```python
import torch

def _softmax(x, axis=-1):
    return torch.softmax(x, dim=axis)
def _gelu(x):
    return torch.nn.functional.gelu(x, approximate="tanh")
def _silu(x):
    return torch.nn.functional.silu(x)
def _sigmoid(x):
    return torch.sigmoid(x)
def _layernorm(x, axis=-1, eps=1e-5):
    m = x.mean(dim=axis, keepdim=True)
    v = x.var(dim=axis, keepdim=True, unbiased=False)
    return (x - m) / torch.sqrt(v + eps)
def _scatter_add(tgt, idx, src, axis=0):
    return tgt.clone().index_add_(axis, idx, src)
def _segment_sum(src, seg, n):
    out = torch.zeros((n,) + src.shape[1:], dtype=src.dtype)
    return out.index_add_(0, seg, src)
def _pad(x, pw):
    flat = tuple(v for pair in reversed(pw) for v in pair)
    return torch.nn.functional.pad(x, flat)

kernel_name = 'standalone__sliding_local_strided__prompt'

def setup_inputs():

    _w = (lambda a: (lambda t: t.to(torch.bfloat16) if t.is_floating_point() else t)(torch.as_tensor(a)))
    B, H, S, D = 1, 16, 2048, 256
    return {
        "q": _w((lambda *s: torch.randn(*s, dtype=torch.bfloat16) * 0.8)(B, H, S, D)),
        "k": _w((lambda *s: torch.randn(*s, dtype=torch.bfloat16) * 0.8)(B, H, S, D)),
        "v": _w((lambda *s: torch.randn(*s, dtype=torch.bfloat16) * 0.05)(B, H, S, D)),
    }

def reference(q, k, v):
    B, H, S, D = q.shape
    W, dil = 8, 4
    scale = D ** -0.5
    pos = torch.arange(S)
    kidx = pos[:, None] - torch.arange(W)[None, :] * dil
    valid = kidx >= 0
    kidx = torch.where(valid, kidx, torch.zeros_like(kidx))
    idx = torch.reshape(kidx, (1, 1, S * W, 1))
    idx = (lambda x, n, axis: torch.repeat_interleave(x, n, dim=axis))(idx, B, 0)
    idx = (lambda x, n, axis: torch.repeat_interleave(x, n, dim=axis))(idx, H, 1)
    idx = (lambda x, n, axis: torch.repeat_interleave(x, n, dim=axis))(idx, D, 3)
    kg = torch.reshape((lambda x, i, axis: torch.take_along_dim(x, i, dim=axis))(k, idx, 2), (B, H, S, W, D))
    vg = torch.reshape((lambda x, i, axis: torch.take_along_dim(x, i, dim=axis))(v, idx, 2), (B, H, S, W, D))
    scores = torch.einsum("bhsd,bhswd->bhsw", q, kg) * scale
    mask_f = (lambda x, dt: x.to(dt))(valid, q.dtype)[None, None, :, :]
    scores = scores + (mask_f - 1.0) * 1e9
    p = _softmax(scores, axis=-1)
    return torch.einsum("bhsw,bhswd->bhsd", p, vg)
```

```asm
; @launch grid=(256,1,1) block=(256,1,1) lds=163840
.amdgcn_target "amdgcn-amd-amdhsa--gfx950"
.text
.globl standalone__sliding_local_strided__prompt_kernel
.p2align 12
.p2align 8
.type standalone__sliding_local_strided__prompt_kernel,@function
standalone__sliding_local_strided__prompt_kernel:
    s_load_dwordx2 s[4:5], s[0:1], 0
    s_load_dwordx2 s[8:9], s[0:1], 8
    s_load_dwordx2 s[12:13], s[0:1], 16
    s_load_dwordx2 s[16:17], s[0:1], 24
    s_cmp_ge_u32 s2, 256
    s_cbranch_scc1 L_end
    v_readfirstlane_b32 s31, v0
    s_and_b32 s28, s2, 7
    s_lshr_b32 s29, s2, 3
    s_lshl_b32 s28, s28, 21
    s_lshl_b32 s30, s29, 16
    s_add_u32 s30, s30, s28
    s_lshl_b32 s33, s31, 3
    s_add_u32 s30, s30, s33
    s_mul_i32 s35, s31, 640
    s_mov_b32 m0, s35
    v_bfe_u32 v3, v0, 5, 1
    v_and_b32 v4, 31, v0
    v_mul_u32_u24 v3, 8224, v3
    v_lshlrev_b32 v4, 4, v4
    v_xor_b32 v5, v3, v4
    v_add_u32 v8, s30, v5
    v_xor_b32 v9, 16, v8
    v_add_u32 v9, 1024, v9
    v_xor_b32 v10, 128, v8
    v_add_u32 v10, 2048, v10
    v_xor_b32 v11, 144, v8
    v_add_u32 v11, 3072, v11
    v_xor_b32 v12, 64, v8
    v_add_u32 v12, 16384, v12
    v_xor_b32 v13, 80, v8
    v_add_u32 v13, 17408, v13
    v_xor_b32 v14, 192, v8
    v_add_u32 v14, 18432, v14
    v_xor_b32 v15, 208, v8
    v_add_u32 v15, 19456, v15
    s_mov_b32 s6, 16777216
    s_mov_b32 s7, 0x20000
    s_waitcnt lgkmcnt(0)
    buffer_load_dwordx4 v8, s[4:7], 0 offen offset:0 nt lds
    buffer_load_dwordx4 v9, s[4:7], 0 offen offset:1024 nt lds
    buffer_load_dwordx4 v10, s[4:7], 0 offen offset:2048 nt lds
    buffer_load_dwordx4 v11, s[4:7], 0 offen offset:3072 nt lds
    s_add_u32 m0, s35, 4096
    s_nop 0
    buffer_load_dwordx4 v12, s[4:7], 0 offen offset:0 nt lds
    buffer_load_dwordx4 v13, s[4:7], 0 offen offset:1024 nt lds
    buffer_load_dwordx4 v14, s[4:7], 0 offen offset:2048 nt lds
    buffer_load_dwordx4 v15, s[4:7], 0 offen offset:3072 nt lds
    s_mov_b32 s34, 0xf8000
    s_and_b32 s29, s29, 15
    s_cmov_b32 s34, 0xffff8000
    s_cselect_b64 s[40:41], -1, 0
    v_or_b32 v16, 8192, v12
    v_add_u32 v16, s34, v16
    v_add_u32 v17, s34, v13
    v_add_u32 v18, s34, v14
    v_add_u32 v19, s34, v15
    s_mov_b32 s10, 16777216
    s_mov_b32 s11, 0x20000
    s_mov_b32 s14, 16777216
    s_mov_b32 s15, 0x20000
    s_mov_b32 s18, 16777216
    s_mov_b32 s19, 0x20000
    s_mov_b32 s39, 0x4000
    s_mov_b32 s36, 0x8000
    s_mov_b32 s37, 0xc000
    s_mov_b32 s38, 0x3db8aa3b
    v_and_b32 v2, 63, v0
    v_and_b32 v3, 15, v2
    v_lshrrev_b32 v4, 4, v2
    v_bfe_u32 v5, v2, 1, 3
    v_and_b32 v6, 1, v2
    v_and_b32 v7, 3, v5
    v_xor_b32 v7, v7, v4
    v_lshl_or_b32 v7, v7, 1, v6
    v_lshlrev_b32 v7, 4, v7
    v_lshl_add_u32 v7, v5, 7, v7
    v_add_u32 v34, s35, v7
    v_lshl_add_u32 v35, v2, 4, s35
    v_lshrrev_b32 v7, 3, v2
    v_and_b32 v32, 3, v7
    v_lshlrev_b32 v32, 1, v32
    v_xor_b32 v32, v32, v2
    v_and_b32 v32, 7, v32
    v_lshlrev_b32 v32, 4, v32
    v_lshl_add_u32 v32, v7, 11, v32
    v_add_u32 v32, s30, v32
    v_lshrrev_b32 v7, 5, v2
    v_xor_b32 v33, v6, v7
    v_subrev_u32 v33, 1, v33
    v_lshl_or_b32 v5, v6, 3, v5
    v_lshlrev_b32 v6, 2, v4
    v_sub_u32 v6, v5, v6
    v_mov_b32 v7, 0xff800000
    v_cmp_gt_u32 s[42:43], 8, v6
    v_cmp_gt_i32 s[44:45], -8, v6
    v_subrev_u32 v6, 1, v6
    v_cndmask_b32 v72, v7, 0, s[42:43]
    v_cndmask_b32 v76, v7, 0, s[44:45]
    v_cndmask_b32 v80, v7, v76, s[40:41]
    v_cmp_gt_u32 s[42:43], 8, v6
    v_cmp_gt_i32 s[44:45], -8, v6
    v_subrev_u32 v6, 1, v6
    v_cndmask_b32 v73, v7, 0, s[42:43]
    v_cndmask_b32 v77, v7, 0, s[44:45]
    v_cndmask_b32 v81, v7, v77, s[40:41]
    v_cmp_gt_u32 s[42:43], 8, v6
    v_cmp_gt_i32 s[44:45], -8, v6
    v_subrev_u32 v6, 1, v6
    v_cndmask_b32 v74, v7, 0, s[42:43]
    v_cndmask_b32 v78, v7, 0, s[44:45]
    v_cndmask_b32 v82, v7, v78, s[40:41]
    v_cmp_gt_u32 s[42:43], 8, v6
    v_cmp_gt_i32 s[44:45], -8, v6
    v_subrev_u32 v6, 1, v6
    v_cndmask_b32 v75, v7, 0, s[42:43]
    v_cndmask_b32 v79, v7, 0, s[44:45]
    v_cndmask_b32 v83, v7, v79, s[40:41]
    v_lshlrev_b32 v7, 4, v4
    v_bfe_i32 v44, v3, 0, 1
    v_and_b32 v44, 1040, v44
    v_xor_b32 v7, v7, v44
    v_bfe_i32 v44, v3, 1, 1
    v_and_b32 v44, 2176, v44
    v_xor_b32 v7, v7, v44
    v_bfe_i32 v44, v3, 2, 1
    v_and_b32 v44, 544, v44
    v_xor_b32 v7, v7, v44
    v_bfe_i32 v44, v3, 3, 1
    v_and_b32 v44, 4160, v44
    v_xor_b32 v7, v7, v44
    v_add_u32 v20, s35, v7
    v_xor_b32 v21, 64, v20
    v_xor_b32 v22, 128, v20
    v_xor_b32 v23, 192, v20
    v_lshlrev_b32 v7, 4, v4
    v_bfe_i32 v44, v5, 0, 1
    v_and_b32 v44, 1040, v44
    v_xor_b32 v7, v7, v44
    v_bfe_i32 v44, v5, 1, 1
    v_and_b32 v44, 2176, v44
    v_xor_b32 v7, v7, v44
    v_bfe_i32 v44, v5, 2, 1
    v_and_b32 v44, 544, v44
    v_xor_b32 v7, v7, v44
    v_bfe_i32 v44, v5, 3, 1
    v_and_b32 v44, 4160, v44
    v_xor_b32 v7, v7, v44
    v_add_u32 v24, s35, v7
    v_xor_b32 v25, 64, v24
    v_xor_b32 v26, 128, v24
    v_xor_b32 v27, 192, v24
    v_bfe_u32 v5, v2, 2, 3
    v_and_b32 v6, 3, v2
    v_lshrrev_b32 v4, 5, v2
    v_lshl_or_b32 v6, v6, 1, v4
    v_lshlrev_b32 v7, 4, v6
    v_bfe_i32 v44, v5, 0, 1
    v_and_b32 v44, 1040, v44
    v_xor_b32 v7, v7, v44
    v_bfe_i32 v44, v5, 1, 1
    v_and_b32 v44, 2176, v44
    v_xor_b32 v7, v7, v44
    v_bfe_i32 v44, v5, 2, 1
    v_and_b32 v44, 544, v44
    v_xor_b32 v7, v7, v44
    v_add_u32 v28, s35, v7
    v_xor_b32 v29, 64, v28
    v_xor_b32 v30, 128, v28
    v_xor_b32 v31, 192, v28
    v_and_b32 v5, 8, v2
    v_cmp_ne_u32 s[42:43], 0, v5
    v_mov_b32 v5, 0x1000
    v_mov_b32 v6, 64
    v_cndmask_b32 v7, v6, v5, s[42:43]
    v_xor_b32 v56, v7, v20
    v_xor_b32 v57, v7, v21
    v_xor_b32 v58, v7, v22
    v_xor_b32 v59, v7, v23
    s_add_u32 m0, s35, 8192
    s_nop 0
    buffer_load_dwordx4 v8, s[4:7], s36 offen offset:0 nt lds
    buffer_load_dwordx4 v9, s[4:7], s36 offen offset:1024 nt lds
    buffer_load_dwordx4 v10, s[4:7], s36 offen offset:2048 nt lds
    buffer_load_dwordx4 v11, s[4:7], s36 offen offset:3072 nt lds
    s_add_u32 m0, s35, 12288
    s_nop 0
    buffer_load_dwordx4 v12, s[4:7], s36 offen offset:0 nt lds
    buffer_load_dwordx4 v13, s[4:7], s36 offen offset:1024 nt lds
    s_add_u32 m0, s35, 16384
    s_nop 0
    buffer_load_dwordx4 v16, s[8:11], 0 offen offset:0 lds
    buffer_load_dwordx4 v17, s[8:11], 0 offen offset:1024 lds
    buffer_load_dwordx4 v18, s[8:11], 0 offen offset:2048 lds
    buffer_load_dwordx4 v19, s[8:11], 0 offen offset:3072 lds
    s_add_u32 m0, s35, 12288
    s_nop 0
    buffer_load_dwordx4 v14, s[4:7], s36 offen offset:2048 nt lds
    s_add_u32 m0, s35, 20480
    s_nop 0
    buffer_load_dwordx4 v8, s[8:11], 0 offen offset:0 nt lds
    buffer_load_dwordx4 v9, s[8:11], 0 offen offset:1024 nt lds
    buffer_load_dwordx4 v10, s[8:11], 0 offen offset:2048 nt lds
    s_add_u32 m0, s35, 12288
    s_nop 0
    buffer_load_dwordx4 v15, s[4:7], s36 offen offset:3072 nt lds
    s_add_u32 m0, s35, 20480
    s_nop 0
    buffer_load_dwordx4 v11, s[8:11], 0 offen offset:3072 nt lds
    s_add_u32 m0, s35, 24576
    s_nop 0
    buffer_load_dwordx4 v12, s[8:11], 0 offen offset:0 nt lds
    buffer_load_dwordx4 v13, s[8:11], 0 offen offset:1024 nt lds
    buffer_load_dwordx4 v14, s[8:11], 0 offen offset:2048 nt lds
    buffer_load_dwordx4 v15, s[8:11], 0 offen offset:3072 nt lds
    s_waitcnt vmcnt(20)
    ds_read_b128 v[84:87], v24 offset:0
    ds_read_b128 v[88:91], v25 offset:0
    ds_read_b128 v[92:95], v26 offset:0
    ds_read_b128 v[96:99], v27 offset:0
    ds_read_b128 v[100:103], v24 offset:256
    ds_read_b128 v[104:107], v25 offset:256
    ds_read_b128 v[108:111], v26 offset:256
    ds_read_b128 v[112:115], v27 offset:256
    s_add_u32 m0, s35, 28672
    s_nop 0
    buffer_load_dwordx4 v8, s[8:11], s36 offen offset:0 nt lds
    buffer_load_dwordx4 v9, s[8:11], s36 offen offset:1024 nt lds
    s_add_u32 m0, s35, 32768
    s_nop 0
    buffer_load_dwordx4 v12, s[8:11], s36 offen offset:0 nt lds
    buffer_load_dwordx4 v13, s[8:11], s36 offen offset:1024 nt lds
    buffer_load_dwordx4 v14, s[8:11], s36 offen offset:2048 nt lds
    buffer_load_dwordx4 v15, s[8:11], s36 offen offset:3072 nt lds
    s_add_u32 m0, s35, 36864
    s_nop 0
    buffer_load_dwordx4 v16, s[12:15], 0 offen offset:0 lds
    buffer_load_dwordx4 v17, s[12:15], 0 offen offset:1024 lds
    buffer_load_dwordx4 v18, s[12:15], 0 offen offset:2048 lds
    buffer_load_dwordx4 v19, s[12:15], 0 offen offset:3072 lds
    s_add_u32 m0, s35, 28672
    s_nop 0
    buffer_load_dwordx4 v10, s[8:11], s36 offen offset:2048 nt lds
    s_waitcnt lgkmcnt(0)
    s_add_u32 m0, s35, 0
    s_nop 0
    buffer_load_dwordx4 v8, s[12:15], 0 offen offset:0 nt lds
    buffer_load_dwordx4 v9, s[12:15], 0 offen offset:1024 nt lds
    buffer_load_dwordx4 v10, s[12:15], 0 offen offset:2048 nt lds
    s_waitcnt vmcnt(19)
    ds_read_b128 v[180:183], v24 offset:8192
    ds_read_b128 v[184:187], v25 offset:8192
    ds_read_b128 v[188:191], v26 offset:8192
    ds_read_b128 v[192:195], v27 offset:8192
    ds_read_b128 v[196:199], v24 offset:8448
    ds_read_b128 v[200:203], v25 offset:8448
    ds_read_b128 v[204:207], v26 offset:8448
    ds_read_b128 v[208:211], v27 offset:8448
    s_waitcnt vmcnt(14)
    ds_read_b128 v[148:151], v20 offset:20480
    ds_read_b128 v[152:155], v21 offset:20480
    ds_read_b128 v[156:159], v22 offset:20480
    ds_read_b128 v[160:163], v23 offset:20480
    ds_read_b128 v[164:167], v20 offset:20736
    ds_read_b128 v[168:171], v21 offset:20736
    ds_read_b128 v[172:175], v22 offset:20736
    ds_read_b128 v[176:179], v23 offset:20736
    ds_read_b128 v[116:119], v56 offset:16384
    ds_read_b128 v[120:123], v57 offset:16384
    ds_read_b128 v[124:127], v58 offset:16384
    ds_read_b128 v[128:131], v59 offset:16384
    ds_read_b128 v[132:135], v56 offset:16640
    ds_read_b128 v[136:139], v57 offset:16640
    ds_read_b128 v[140:143], v58 offset:16640
    ds_read_b128 v[144:147], v59 offset:16640
    s_waitcnt lgkmcnt(8)
    v_mfma_f32_16x16x32_bf16 v[36:39], v[148:151], v[84:87], v[72:75]
    v_mfma_f32_16x16x32_bf16 v[36:39], v[152:155], v[88:91], v[36:39]
    v_mfma_f32_16x16x32_bf16 v[36:39], v[156:159], v[92:95], v[36:39]
    v_mfma_f32_16x16x32_bf16 v[36:39], v[160:163], v[96:99], v[36:39]
    v_mfma_f32_16x16x32_bf16 v[36:39], v[164:167], v[100:103], v[36:39]
    v_mfma_f32_16x16x32_bf16 v[36:39], v[168:171], v[104:107], v[36:39]
    v_mfma_f32_16x16x32_bf16 v[36:39], v[172:175], v[108:111], v[36:39]
    v_mfma_f32_16x16x32_bf16 v[36:39], v[176:179], v[112:115], v[36:39]
    s_waitcnt lgkmcnt(0)
    v_mfma_f32_16x16x32_bf16 v[40:43], v[116:119], v[84:87], v[80:83]
    v_mfma_f32_16x16x32_bf16 v[40:43], v[120:123], v[88:91], v[40:43]
    v_mfma_f32_16x16x32_bf16 v[40:43], v[124:127], v[92:95], v[40:43]
    v_mfma_f32_16x16x32_bf16 v[40:43], v[128:131], v[96:99], v[40:43]
    v_mfma_f32_16x16x32_bf16 v[40:43], v[132:135], v[100:103], v[40:43]
    v_mfma_f32_16x16x32_bf16 v[40:43], v[136:139], v[104:107], v[40:43]
    v_mfma_f32_16x16x32_bf16 v[40:43], v[140:143], v[108:111], v[40:43]
    v_mfma_f32_16x16x32_bf16 v[40:43], v[144:147], v[112:115], v[40:43]
    s_nop 7
    v_max_f32 v36, v36, v40
    v_max_f32 v37, v37, v41
    v_max_f32 v38, v38, v42
    v_max_f32 v39, v39, v43
    v_cvt_pk_bf16_f32 v44, v36, v37
    v_cvt_pk_bf16_f32 v45, v38, v39
    v_lshlrev_b32 v36, 16, v44
    v_and_b32 v37, 0xffff0000, v44
    v_lshlrev_b32 v38, 16, v45
    v_and_b32 v39, 0xffff0000, v45
    v_max3_f32 v44, v36, v37, v38
    v_max_f32 v45, v44, v39
    v_max_f32 v44, v44, v39
    s_nop 1
    v_permlane32_swap_b32 v44, v45
    v_max_f32 v46, v44, v45
    v_max_f32 v44, v44, v45
    s_nop 1
    v_permlane16_swap_b32 v44, v46
    v_max_f32 v44, v44, v46
    v_sub_f32 v36, v36, v44
    v_sub_f32 v37, v37, v44
    v_sub_f32 v38, v38, v44
    v_sub_f32 v39, v39, v44
    v_mul_f32 v36, s38, v36
    v_mul_f32 v37, s38, v37
    v_mul_f32 v38, s38, v38
    v_mul_f32 v39, s38, v39
    v_exp_f32 v36, v36
    v_exp_f32 v37, v37
    v_exp_f32 v38, v38
    v_exp_f32 v39, v39
    v_add_f32 v44, v36, v37
    v_add_f32 v46, v38, v39
    v_add_f32 v45, v44, v46
    v_add_f32 v44, v44, v46
    s_nop 1
    v_permlane32_swap_b32 v44, v45
    v_add_f32 v46, v44, v45
    v_add_f32 v44, v44, v45
    s_nop 1
    v_permlane16_swap_b32 v44, v46
    v_add_f32 v44, v44, v46
    v_rcp_f32 v44, v44
    s_nop 0
    v_mul_f32 v36, v36, v44
    v_mul_f32 v37, v37, v44
    v_mul_f32 v38, v38, v44
    v_mul_f32 v39, v39, v44
    v_cvt_pk_bf16_f32 v44, v36, v37
    v_cvt_pk_bf16_f32 v46, v36, v37
    v_cvt_pk_bf16_f32 v45, v38, v39
    v_cvt_pk_bf16_f32 v47, v38, v39
    v_permlane32_swap_b32 v44, v46
    s_nop 0
    v_permlane32_swap_b32 v45, v47
    v_and_b32_dpp v48, v46, v33 quad_perm:[0,0,2,2] row_mask:0xf bank_mask:0xf
    v_and_b32_dpp v50, v44, v33 quad_perm:[0,0,2,2] row_mask:0xf bank_mask:0xf
    v_and_b32_dpp v49, v47, v33 quad_perm:[0,0,2,2] row_mask:0xf bank_mask:0xf
    v_and_b32_dpp v51, v45, v33 quad_perm:[0,0,2,2] row_mask:0xf bank_mask:0xf
    v_and_b32_dpp v52, v44, v33 quad_perm:[1,1,3,3] row_mask:0xf bank_mask:0xf
    v_and_b32_dpp v53, v45, v33 quad_perm:[1,1,3,3] row_mask:0xf bank_mask:0xf
    v_and_b32_dpp v54, v46, v33 quad_perm:[1,1,3,3] row_mask:0xf bank_mask:0xf
    v_and_b32_dpp v55, v47, v33 quad_perm:[1,1,3,3] row_mask:0xf bank_mask:0xf
    buffer_load_dwordx4 v11, s[12:15], 0 offen offset:3072 nt lds
    s_add_u32 m0, s35, 12288
    s_nop 0
    buffer_load_dwordx4 v12, s[12:15], s36 offen offset:0 nt lds
    buffer_load_dwordx4 v13, s[12:15], s36 offen offset:1024 nt lds
    buffer_load_dwordx4 v14, s[12:15], s36 offen offset:2048 nt lds
    buffer_load_dwordx4 v15, s[12:15], s36 offen offset:3072 nt lds
    s_add_u32 m0, s35, 4096
    s_nop 0
    buffer_load_dwordx4 v12, s[12:15], 0 offen offset:0 nt lds
    s_add_u32 m0, s35, 28672
    s_nop 0
    buffer_load_dwordx4 v11, s[8:11], s36 offen offset:3072 nt lds
    s_add_u32 m0, s35, 4096
    s_nop 0
    buffer_load_dwordx4 v13, s[12:15], 0 offen offset:1024 nt lds
    buffer_load_dwordx4 v14, s[12:15], 0 offen offset:2048 nt lds
    buffer_load_dwordx4 v15, s[12:15], 0 offen offset:3072 nt lds
    s_barrier
    s_add_u32 m0, s35, 8192
    s_nop 0
    buffer_load_dwordx4 v8, s[12:15], s36 offen offset:0 nt lds
    buffer_load_dwordx4 v9, s[12:15], s36 offen offset:1024 nt lds
    buffer_load_dwordx4 v10, s[12:15], s36 offen offset:2048 nt lds
    buffer_load_dwordx4 v11, s[12:15], s36 offen offset:3072 nt lds
    s_waitcnt vmcnt(13)
    ds_read_b64_tr_b16 a[0:1], v29 offset:36864
    ds_read_b64_tr_b16 a[2:3], v28 offset:0
    ds_read_b64_tr_b16 a[10:11], v29 offset:36872
    ds_read_b64_tr_b16 a[12:13], v28 offset:8
    ds_read_b64_tr_b16 a[20:21], v31 offset:36864
    ds_read_b64_tr_b16 a[22:23], v30 offset:0
    ds_read_b64_tr_b16 a[30:31], v31 offset:36872
    ds_read_b64_tr_b16 a[32:33], v30 offset:8
    ds_read_b64_tr_b16 a[40:41], v29 offset:37120
    ds_read_b64_tr_b16 a[42:43], v28 offset:256
    ds_read_b64_tr_b16 a[50:51], v29 offset:37128
    ds_read_b64_tr_b16 a[52:53], v28 offset:264
    ds_read_b64_tr_b16 a[60:61], v31 offset:37120
    ds_read_b64_tr_b16 a[62:63], v30 offset:256
    ds_read_b64_tr_b16 a[70:71], v31 offset:37128
    ds_read_b64_tr_b16 a[72:73], v30 offset:264
    s_waitcnt lgkmcnt(12)
    v_mfma_f32_16x16x32_bf16 v[56:59], a[0:3], v[48:51], 0
    v_mfma_f32_16x16x32_bf16 v[60:63], a[10:13], v[48:51], 0
    s_waitcnt lgkmcnt(8)
    v_mfma_f32_16x16x32_bf16 v[64:67], a[20:23], v[48:51], 0
    v_mfma_f32_16x16x32_bf16 v[68:71], a[30:33], v[48:51], 0
    s_nop 4
    v_cvt_pk_bf16_f32 v212, v56, v57
    v_cvt_pk_bf16_f32 v213, v58, v59
    v_cvt_pk_bf16_f32 v214, v60, v61
    v_cvt_pk_bf16_f32 v215, v62, v63
    ds_write_b128 v34, v[212:215] offset:20480
    ds_read_b128 v[84:87], v35 offset:20480
    s_waitcnt lgkmcnt(6)
    v_mfma_f32_16x16x32_bf16 v[56:59], a[40:43], v[48:51], 0
    v_mfma_f32_16x16x32_bf16 v[60:63], a[50:53], v[48:51], 0
    v_cvt_pk_bf16_f32 v216, v64, v65
    v_cvt_pk_bf16_f32 v217, v66, v67
    v_cvt_pk_bf16_f32 v218, v68, v69
    v_cvt_pk_bf16_f32 v219, v70, v71
    ds_write_b128 v34, v[216:219] offset:21504
    ds_read_b128 v[88:91], v35 offset:21504
    s_waitcnt lgkmcnt(4)
    v_mfma_f32_16x16x32_bf16 v[64:67], a[60:63], v[48:51], 0
    v_mfma_f32_16x16x32_bf16 v[68:71], a[70:73], v[48:51], 0
    v_cvt_pk_bf16_f32 v212, v56, v57
    v_cvt_pk_bf16_f32 v213, v58, v59
    v_cvt_pk_bf16_f32 v214, v60, v61
    v_cvt_pk_bf16_f32 v215, v62, v63
    ds_write_b128 v34, v[212:215] offset:22528
    ds_read_b128 v[92:95], v35 offset:22528
    s_nop 0
    v_cvt_pk_bf16_f32 v216, v64, v65
    v_cvt_pk_bf16_f32 v217, v66, v67
    v_cvt_pk_bf16_f32 v218, v68, v69
    v_cvt_pk_bf16_f32 v219, v70, v71
    ds_write_b128 v34, v[216:219] offset:23552
    ds_read_b128 v[96:99], v35 offset:23552
    v_mfma_f32_16x16x32_bf16 v[40:43], v[148:151], v[180:183], v[76:79]
    v_mfma_f32_16x16x32_bf16 v[40:43], v[152:155], v[184:187], v[40:43]
    v_mfma_f32_16x16x32_bf16 v[40:43], v[156:159], v[188:191], v[40:43]
    v_mfma_f32_16x16x32_bf16 v[40:43], v[160:163], v[192:195], v[40:43]
    v_mfma_f32_16x16x32_bf16 v[40:43], v[164:167], v[196:199], v[40:43]
    v_mfma_f32_16x16x32_bf16 v[40:43], v[168:171], v[200:203], v[40:43]
    v_mfma_f32_16x16x32_bf16 v[40:43], v[172:175], v[204:207], v[40:43]
    v_mfma_f32_16x16x32_bf16 v[40:43], v[176:179], v[208:211], v[40:43]
    s_waitcnt vmcnt(7)
    ds_read_b128 v[116:119], v20 offset:28672
    ds_read_b128 v[120:123], v21 offset:28672
    ds_read_b128 v[124:127], v22 offset:28672
    ds_read_b128 v[128:131], v23 offset:28672
    ds_read_b128 v[132:135], v20 offset:28928
    ds_read_b128 v[136:139], v21 offset:28928
    ds_read_b128 v[140:143], v22 offset:28928
    ds_read_b128 v[144:147], v23 offset:28928
    s_waitcnt lgkmcnt(7)
    v_mfma_f32_16x16x32_bf16 v[36:39], v[116:119], v[180:183], v[72:75]
    s_waitcnt lgkmcnt(6)
    v_mfma_f32_16x16x32_bf16 v[36:39], v[120:123], v[184:187], v[36:39]
    s_waitcnt lgkmcnt(5)
    v_mfma_f32_16x16x32_bf16 v[36:39], v[124:127], v[188:191], v[36:39]
    s_waitcnt lgkmcnt(4)
    v_mfma_f32_16x16x32_bf16 v[36:39], v[128:131], v[192:195], v[36:39]
    s_waitcnt lgkmcnt(3)
    v_mfma_f32_16x16x32_bf16 v[36:39], v[132:135], v[196:199], v[36:39]
    s_waitcnt lgkmcnt(2)
    v_mfma_f32_16x16x32_bf16 v[36:39], v[136:139], v[200:203], v[36:39]
    s_waitcnt lgkmcnt(1)
    v_mfma_f32_16x16x32_bf16 v[36:39], v[140:143], v[204:207], v[36:39]
    s_waitcnt lgkmcnt(0)
    v_mfma_f32_16x16x32_bf16 v[36:39], v[144:147], v[208:211], v[36:39]
    s_nop 7
    v_max_f32 v36, v36, v40
    v_max_f32 v37, v37, v41
    v_max_f32 v38, v38, v42
    v_max_f32 v39, v39, v43
    v_cvt_pk_bf16_f32 v44, v36, v37
    v_cvt_pk_bf16_f32 v45, v38, v39
    v_lshlrev_b32 v36, 16, v44
    v_and_b32 v37, 0xffff0000, v44
    v_lshlrev_b32 v38, 16, v45
    v_and_b32 v39, 0xffff0000, v45
    v_max3_f32 v44, v36, v37, v38
    v_max_f32 v45, v44, v39
    v_max_f32 v44, v44, v39
    s_nop 1
    v_permlane32_swap_b32 v44, v45
    v_max_f32 v46, v44, v45
    v_max_f32 v44, v44, v45
    s_nop 1
    v_permlane16_swap_b32 v44, v46
    v_max_f32 v44, v44, v46
    v_sub_f32 v36, v36, v44
    v_sub_f32 v37, v37, v44
    v_sub_f32 v38, v38, v44
    v_sub_f32 v39, v39, v44
    v_mul_f32 v36, s38, v36
    v_mul_f32 v37, s38, v37
    v_mul_f32 v38, s38, v38
    v_mul_f32 v39, s38, v39
    v_exp_f32 v36, v36
    v_exp_f32 v37, v37
    v_exp_f32 v38, v38
    v_exp_f32 v39, v39
    v_add_f32 v44, v36, v37
    v_add_f32 v46, v38, v39
    v_add_f32 v45, v44, v46
    v_add_f32 v44, v44, v46
    s_nop 1
    v_permlane32_swap_b32 v44, v45
    v_add_f32 v46, v44, v45
    v_add_f32 v44, v44, v45
    s_nop 1
    v_permlane16_swap_b32 v44, v46
    v_add_f32 v44, v44, v46
    v_rcp_f32 v44, v44
    s_nop 0
    v_mul_f32 v36, v36, v44
    v_mul_f32 v37, v37, v44
    v_mul_f32 v38, v38, v44
    v_mul_f32 v39, v39, v44
    v_cvt_pk_bf16_f32 v44, v36, v37
    v_cvt_pk_bf16_f32 v46, v36, v37
    v_cvt_pk_bf16_f32 v45, v38, v39
    v_cvt_pk_bf16_f32 v47, v38, v39
    v_permlane32_swap_b32 v44, v46
    s_nop 0
    v_permlane32_swap_b32 v45, v47
    v_and_b32_dpp v220, v46, v33 quad_perm:[0,0,2,2] row_mask:0xf bank_mask:0xf
    v_and_b32_dpp v222, v44, v33 quad_perm:[0,0,2,2] row_mask:0xf bank_mask:0xf
    v_and_b32_dpp v221, v47, v33 quad_perm:[0,0,2,2] row_mask:0xf bank_mask:0xf
    v_and_b32_dpp v223, v45, v33 quad_perm:[0,0,2,2] row_mask:0xf bank_mask:0xf
    v_and_b32_dpp v224, v44, v33 quad_perm:[1,1,3,3] row_mask:0xf bank_mask:0xf
    v_and_b32_dpp v225, v45, v33 quad_perm:[1,1,3,3] row_mask:0xf bank_mask:0xf
    v_and_b32_dpp v226, v46, v33 quad_perm:[1,1,3,3] row_mask:0xf bank_mask:0xf
    v_and_b32_dpp v227, v47, v33 quad_perm:[1,1,3,3] row_mask:0xf bank_mask:0xf
    s_waitcnt vmcnt(4)
    ds_read_b64_tr_b16 a[4:5], v29 offset:4096
    ds_read_b64_tr_b16 a[14:15], v29 offset:4104
    ds_read_b64_tr_b16 a[24:25], v31 offset:4096
    ds_read_b64_tr_b16 a[34:35], v31 offset:4104
    ds_read_b64_tr_b16 a[44:45], v29 offset:4352
    ds_read_b64_tr_b16 a[54:55], v29 offset:4360
    ds_read_b64_tr_b16 a[64:65], v31 offset:4352
    ds_read_b64_tr_b16 a[74:75], v31 offset:4360
    s_waitcnt lgkmcnt(6)
    v_mfma_f32_16x16x32_bf16 v[56:59], a[2:5], v[52:55], 0
    v_mfma_f32_16x16x32_bf16 v[60:63], a[12:15], v[52:55], 0
    s_waitcnt lgkmcnt(4)
    v_mfma_f32_16x16x32_bf16 v[64:67], a[22:25], v[52:55], 0
    v_mfma_f32_16x16x32_bf16 v[68:71], a[32:35], v[52:55], 0
    s_nop 4
    v_cvt_pk_bf16_f32 v212, v56, v57
    v_cvt_pk_bf16_f32 v213, v58, v59
    v_cvt_pk_bf16_f32 v214, v60, v61
    v_cvt_pk_bf16_f32 v215, v62, v63
    ds_write_b128 v34, v[212:215] offset:24576
    ds_read_b128 v[100:103], v35 offset:24576
    s_waitcnt lgkmcnt(4)
    v_mfma_f32_16x16x32_bf16 v[56:59], a[42:45], v[52:55], 0
    v_mfma_f32_16x16x32_bf16 v[60:63], a[52:55], v[52:55], 0
    v_cvt_pk_bf16_f32 v216, v64, v65
    v_cvt_pk_bf16_f32 v217, v66, v67
    v_cvt_pk_bf16_f32 v218, v68, v69
    v_cvt_pk_bf16_f32 v219, v70, v71
    ds_write_b128 v34, v[216:219] offset:25600
    ds_read_b128 v[104:107], v35 offset:25600
    s_waitcnt lgkmcnt(4)
    v_mfma_f32_16x16x32_bf16 v[64:67], a[62:65], v[52:55], 0
    v_mfma_f32_16x16x32_bf16 v[68:71], a[72:75], v[52:55], 0
    v_cvt_pk_bf16_f32 v212, v56, v57
    v_cvt_pk_bf16_f32 v213, v58, v59
    v_cvt_pk_bf16_f32 v214, v60, v61
    v_cvt_pk_bf16_f32 v215, v62, v63
    ds_write_b128 v34, v[212:215] offset:26624
    ds_read_b128 v[108:111], v35 offset:26624
    s_nop 0
    v_cvt_pk_bf16_f32 v216, v64, v65
    v_cvt_pk_bf16_f32 v217, v66, v67
    v_cvt_pk_bf16_f32 v218, v68, v69
    v_cvt_pk_bf16_f32 v219, v70, v71
    ds_write_b128 v34, v[216:219] offset:27648
    ds_read_b128 v[112:115], v35 offset:27648
    ds_read_b64_tr_b16 a[8:9], v29 offset:12288
    ds_read_b64_tr_b16 a[18:19], v29 offset:12296
    ds_read_b64_tr_b16 a[28:29], v31 offset:12288
    ds_read_b64_tr_b16 a[38:39], v31 offset:12296
    ds_read_b64_tr_b16 a[48:49], v29 offset:12544
    ds_read_b64_tr_b16 a[58:59], v29 offset:12552
    ds_read_b64_tr_b16 a[68:69], v31 offset:12544
    ds_read_b64_tr_b16 a[78:79], v31 offset:12552
    s_waitcnt vmcnt(0)
    ds_read_b64_tr_b16 a[6:7], v28 offset:8192
    ds_read_b64_tr_b16 a[16:17], v28 offset:8200
    ds_read_b64_tr_b16 a[26:27], v30 offset:8192
    ds_read_b64_tr_b16 a[36:37], v30 offset:8200
    ds_read_b64_tr_b16 a[46:47], v28 offset:8448
    ds_read_b64_tr_b16 a[56:57], v28 offset:8456
    ds_read_b64_tr_b16 a[66:67], v30 offset:8448
    ds_read_b64_tr_b16 a[76:77], v30 offset:8456
    s_waitcnt lgkmcnt(6)
    v_mfma_f32_16x16x32_bf16 v[56:59], a[4:7], v[220:223], 0
    v_mfma_f32_16x16x32_bf16 v[60:63], a[14:17], v[220:223], 0
    buffer_store_dwordx4 v[84:87], v32, s[16:19], 0 offen offset:0 nt
    v_mfma_f32_16x16x32_bf16 v[64:67], a[6:9], v[224:227], 0
    v_mfma_f32_16x16x32_bf16 v[68:71], a[16:19], v[224:227], 0
    s_nop 4
    v_cvt_pk_bf16_f32 v212, v56, v57
    v_cvt_pk_bf16_f32 v213, v58, v59
    v_cvt_pk_bf16_f32 v214, v60, v61
    v_cvt_pk_bf16_f32 v215, v62, v63
    ds_write_b128 v34, v[212:215] offset:20480
    ds_read_b128 v[180:183], v35 offset:20480
    buffer_store_dwordx4 v[88:91], v32, s[16:19], 0 offen offset:128 nt
    s_waitcnt lgkmcnt(6)
    v_mfma_f32_16x16x32_bf16 v[56:59], a[24:27], v[220:223], 0
    v_mfma_f32_16x16x32_bf16 v[60:63], a[34:37], v[220:223], 0
    v_cvt_pk_bf16_f32 v216, v64, v65
    v_cvt_pk_bf16_f32 v217, v66, v67
    v_cvt_pk_bf16_f32 v218, v68, v69
    v_cvt_pk_bf16_f32 v219, v70, v71
    ds_write_b128 v34, v[216:219] offset:24576
    ds_read_b128 v[196:199], v35 offset:24576
    buffer_store_dwordx4 v[92:95], v32, s[16:19], 0 offen offset:256 nt
    v_mfma_f32_16x16x32_bf16 v[64:67], a[26:29], v[224:227], 0
    v_mfma_f32_16x16x32_bf16 v[68:71], a[36:39], v[224:227], 0
    v_cvt_pk_bf16_f32 v212, v56, v57
    v_cvt_pk_bf16_f32 v213, v58, v59
    v_cvt_pk_bf16_f32 v214, v60, v61
    v_cvt_pk_bf16_f32 v215, v62, v63
    ds_write_b128 v34, v[212:215] offset:21504
    ds_read_b128 v[184:187], v35 offset:21504
    buffer_store_dwordx4 v[96:99], v32, s[16:19], 0 offen offset:384 nt
    s_waitcnt lgkmcnt(8)
    v_mfma_f32_16x16x32_bf16 v[56:59], a[44:47], v[220:223], 0
    v_mfma_f32_16x16x32_bf16 v[60:63], a[54:57], v[220:223], 0
    v_cvt_pk_bf16_f32 v216, v64, v65
    v_cvt_pk_bf16_f32 v217, v66, v67
    v_cvt_pk_bf16_f32 v218, v68, v69
    v_cvt_pk_bf16_f32 v219, v70, v71
    ds_write_b128 v34, v[216:219] offset:25600
    ds_read_b128 v[200:203], v35 offset:25600
    buffer_store_dwordx4 v[100:103], v32, s[16:19], s39 offen offset:0 nt
    v_mfma_f32_16x16x32_bf16 v[64:67], a[46:49], v[224:227], 0
    v_mfma_f32_16x16x32_bf16 v[68:71], a[56:59], v[224:227], 0
    v_cvt_pk_bf16_f32 v212, v56, v57
    v_cvt_pk_bf16_f32 v213, v58, v59
    v_cvt_pk_bf16_f32 v214, v60, v61
    v_cvt_pk_bf16_f32 v215, v62, v63
    ds_write_b128 v34, v[212:215] offset:22528
    ds_read_b128 v[188:191], v35 offset:22528
    buffer_store_dwordx4 v[104:107], v32, s[16:19], s39 offen offset:128 nt
    s_waitcnt lgkmcnt(10)
    v_mfma_f32_16x16x32_bf16 v[56:59], a[64:67], v[220:223], 0
    v_mfma_f32_16x16x32_bf16 v[60:63], a[74:77], v[220:223], 0
    v_cvt_pk_bf16_f32 v216, v64, v65
    v_cvt_pk_bf16_f32 v217, v66, v67
    v_cvt_pk_bf16_f32 v218, v68, v69
    v_cvt_pk_bf16_f32 v219, v70, v71
    ds_write_b128 v34, v[216:219] offset:26624
    ds_read_b128 v[204:207], v35 offset:26624
    buffer_store_dwordx4 v[108:111], v32, s[16:19], s39 offen offset:256 nt
    v_mfma_f32_16x16x32_bf16 v[64:67], a[66:69], v[224:227], 0
    v_mfma_f32_16x16x32_bf16 v[68:71], a[76:79], v[224:227], 0
    v_cvt_pk_bf16_f32 v212, v56, v57
    v_cvt_pk_bf16_f32 v213, v58, v59
    v_cvt_pk_bf16_f32 v214, v60, v61
    v_cvt_pk_bf16_f32 v215, v62, v63
    ds_write_b128 v34, v[212:215] offset:23552
    ds_read_b128 v[192:195], v35 offset:23552
    buffer_store_dwordx4 v[112:115], v32, s[16:19], s39 offen offset:384 nt
    s_nop 0
    v_cvt_pk_bf16_f32 v216, v64, v65
    v_cvt_pk_bf16_f32 v217, v66, v67
    v_cvt_pk_bf16_f32 v218, v68, v69
    v_cvt_pk_bf16_f32 v219, v70, v71
    ds_write_b128 v34, v[216:219] offset:27648
    ds_read_b128 v[208:211], v35 offset:27648
    s_waitcnt lgkmcnt(14)
    buffer_store_dwordx4 v[180:183], v32, s[16:19], s36 offen offset:0 nt
    s_waitcnt lgkmcnt(12)
    buffer_store_dwordx4 v[196:199], v32, s[16:19], s37 offen offset:0 nt
    s_waitcnt lgkmcnt(10)
    buffer_store_dwordx4 v[184:187], v32, s[16:19], s36 offen offset:128 nt
    s_waitcnt lgkmcnt(8)
    buffer_store_dwordx4 v[200:203], v32, s[16:19], s37 offen offset:128 nt
    s_waitcnt lgkmcnt(6)
    buffer_store_dwordx4 v[188:191], v32, s[16:19], s36 offen offset:256 nt
    s_waitcnt lgkmcnt(4)
    buffer_store_dwordx4 v[204:207], v32, s[16:19], s37 offen offset:256 nt
    s_waitcnt lgkmcnt(2)
    buffer_store_dwordx4 v[192:195], v32, s[16:19], s36 offen offset:384 nt
    s_waitcnt lgkmcnt(0)
    buffer_store_dwordx4 v[208:211], v32, s[16:19], s37 offen offset:384 nt
L_end:
    s_endpgm
.section .rodata,"a"
.p2align 6
.amdhsa_kernel standalone__sliding_local_strided__prompt_kernel
  .amdhsa_next_free_vgpr 308
  .amdhsa_next_free_sgpr 46
  .amdhsa_accum_offset 228
  .amdhsa_group_segment_fixed_size 0
  .amdhsa_kernarg_size 48
  .amdhsa_user_sgpr_count 2
  .amdhsa_user_sgpr_kernarg_segment_ptr 1
  .amdhsa_system_sgpr_workgroup_id_x 1
.end_amdhsa_kernel
```
